```python
import torch

def _softmax(x, axis=-1):
    return torch.softmax(x, dim=axis)
def _gelu(x):
    return torch.nn.functional.gelu(x, approximate="tanh")
def _silu(x):
    return torch.nn.functional.silu(x)
def _sigmoid(x):
    return torch.sigmoid(x)
def _layernorm(x, axis=-1, eps=1e-5):
    m = x.mean(dim=axis, keepdim=True)
    v = x.var(dim=axis, keepdim=True, unbiased=False)
    return (x - m) / torch.sqrt(v + eps)
def _scatter_add(tgt, idx, src, axis=0):
    return tgt.clone().index_add_(axis, idx, src)
def _segment_sum(src, seg, n):
    out = torch.zeros((n,) + src.shape[1:], dtype=src.dtype)
    return out.index_add_(0, seg, src)
def _pad(x, pw):
    flat = tuple(v for pair in reversed(pw) for v in pair)
    return torch.nn.functional.pad(x, flat)

kernel_name = 'standalone__instancenorm__sampling'

def setup_inputs():

    _w = (lambda a: (lambda t: t.to(torch.bfloat16) if t.is_floating_point() else t)(torch.as_tensor(a)))
    B, C, H, W = 64, 1024, 4, 32
    return {
        "x": _w(abs((lambda *s: torch.randn(*s, dtype=torch.bfloat16) * 0.05)(B, C, H, W))),
        "g": _w((lambda *s: torch.randn(*s, dtype=torch.bfloat16) * 0.05)(C) + 1.0),
        "b": _w((lambda *s: torch.randn(*s, dtype=torch.bfloat16) * 0.4)(C)),
    }

def reference(x, g, b):
    mu = x.mean(axis=(-2, -1), keepdims=True)
    var = ((x - mu) ** 2).mean(axis=(-2, -1), keepdims=True)
    xhat = (x - mu) / torch.sqrt(var + 1e-5)
    return xhat * g.reshape(1, -1, 1, 1) + b.reshape(1, -1, 1, 1)
```

```asm
; @launch grid=(1024,1,1) block=(256,1,1) lds=0
.amdgcn_target "amdgcn-amd-amdhsa--gfx950"
.text
.p2align 13
.globl standalone__instancenorm__sampling_kernel
.p2align 8
.type standalone__instancenorm__sampling_kernel,@function
standalone__instancenorm__sampling_kernel:
    s_load_dwordx8 s[4:11], s[0:1], 0
    s_lshr_b32 s3, s2, 6
    s_and_b32 s3, s3, 12
    s_xor_b32 s3, s3, s2
    s_mul_i32 s3, s3, 0x80200
    s_and_b32 s24, s3, 0x3ff000
    v_lshl_add_u32 v1, v0, 4, s24
    s_cmp_lt_u32 s2, 16
    s_cbranch_scc1 L_probe
L_go:
    s_waitcnt lgkmcnt(0)
    global_load_dwordx4 v[8:11], v1, s[4:5] nt
    v_bfe_u32 v0, v1, 8, 10
    v_lshlrev_b32 v0, 1, v0
    global_load_ushort v16, v0, s[6:7]
    global_load_ushort v5, v0, s[8:9]
    s_branch L_main

L_probe:
    s_load_dwordx2 s[16:17], s[0:1], 32
    v_readfirstlane_b32 s19, v0
    s_getreg_b32 s18, hwreg(HW_REG_XCC_ID, 0, 3)
    s_mul_i32 s33, s2, 0x420
    s_or_b32 s33, s33, 0xc00000
    s_xor_b32 s34, s33, 0x7000
    s_mov_b32 s35, -1
    s_and_b32 s3, s18, 1
    s_or_b32 s3, s3, s19
    s_cbranch_scc1 L_go
    v_bfe_u32 v0, v1, 8, 10
    v_lshlrev_b32 v0, 1, v0
    v_mov_b32 v7, 0
    s_waitcnt lgkmcnt(0)
    s_and_b32 s3, s4, 0x7fff
    s_sub_u32 s33, s33, s3
    s_sub_u32 s34, s34, s3
    s_load_dword s36, s[4:5], s33 glc
    s_load_dword s35, s[4:5], s34 glc
    global_load_dwordx4 v[8:11], v1, s[4:5] nt
    global_load_ushort v16, v0, s[6:7]
    global_load_ushort v5, v0, s[8:9]
    s_lshr_b32 s37, s4, 19
    s_lshr_b32 s33, s2, 1
    s_waitcnt lgkmcnt(1)
    s_xor_b32 s33, s33, s37
    s_and_b32 s33, s33, 4
    s_and_b32 s3, s18, 3
    s_add_u32 s3, s3, s33
    s_sub_u32 s3, s3, s2
    s_and_b32 s3, s3, 7
    s_lshr_b32 s3, 0xf0f0f0f0, s3
    s_cmp_eq_u32 s18, 2
    s_cselect_b32 s33, 0xff0, 0
    s_cmp_eq_u32 s35, -1
    s_cselect_b32 s3, s3, s33
    s_cmp_eq_u32 s3, 0
    s_cbranch_scc1 L_main
    v_mov_b32 v6, s3
    s_mov_b64 exec, 1
    global_atomic_cmpswap v7, v[6:7], s[16:17] sc1
    s_mov_b64 exec, -1

L_main:
    s_load_dwordx2 s[16:17], s[0:1], 32
    s_cmp_ge_u32 s2, 0x400
    s_cbranch_scc1 L_end
    s_cmp_lt_u32 s2, 0x100
    s_cbranch_scc1 L_prio
    s_setprio 1
    s_cmp_lt_u32 s2, 0x200
    s_cbranch_scc1 L_prio
    s_setprio 2
    s_cmp_lt_u32 s2, 0x300
    s_cbranch_scc1 L_prio
    s_setprio 3
L_prio:
    v_xor_b32 v0, 0x680000, v1
    v_and_b32 v17, 0x30, v1
    v_mov_b32 v18, 0x3f80
    v_mov_b32 v19, 0
    v_lshlrev_b64 v[18:19], v17, v[18:19]
    s_mov_b32 s20, 0xbc00bc00
    s_mov_b32 s22, 0x3827c5ac
    s_mov_b32 s23, s22
    s_lshl_b32 s25, s2, 19
    s_xor_b32 s3, s24, 0x800000
    s_add_u32 s3, s3, s4
    s_lshl_b32 s26, s3, 8
    s_xor_b32 s26, s26, s3
    s_xor_b32 s26, s26, s25
    s_and_b32 s26, s26, 0x200000
    s_or_b32 s26, s26, 0x800000
    s_xor_b32 s3, s24, 0xc80000
    s_add_u32 s3, s3, s4
    s_lshl_b32 s28, s3, 8
    s_xor_b32 s28, s28, s3
    s_xor_b32 s28, s28, s25
    s_and_b32 s28, s28, 0x200000
    s_or_b32 s28, s28, 0xc80000
    s_xor_b32 s27, s26, 0x200000
    s_xor_b32 s29, s28, 0x200000
    s_and_b32 s30, s2, 3
    s_or_b32 s31, s30, 8
    s_waitcnt vmcnt(2) lgkmcnt(0)
    global_load_dwordx4 v[12:15], v0, s[4:5] nt
    v_dot2_f32_bf16 v4, v8, s20, 0
    v_dot2_f32_bf16 v4, v9, s20, v4
    v_dot2_f32_bf16 v4, v10, s20, v4
    v_dot2_f32_bf16 v4, v11, s20, v4
    v_mfma_f32_4x4x4_16b_bf16 v[20:23], v[18:19], v[8:9], 0
    v_mfma_f32_4x4x4_16b_bf16 v[24:27], v[18:19], v[10:11], 0
    s_nop 0
    v_add_f32_dpp v4, v4, v4 row_ror:8 row_mask:0xf bank_mask:0xf
    s_nop 1
    v_add_f32_dpp v4, v4, v4 row_ror:4 row_mask:0xf bank_mask:0xf
    s_nop 1
    v_add_f32_dpp v4, v4, v4 row_ror:2 row_mask:0xf bank_mask:0xf
    s_nop 1
    v_add_f32_dpp v4, v4, v4 row_ror:1 row_mask:0xf bank_mask:0xf
    v_pk_add_f32 v[20:21], v[20:21], v[4:5] op_sel_hi:[1,0]
    v_pk_add_f32 v[22:23], v[22:23], v[4:5] op_sel_hi:[1,0]
    v_pk_add_f32 v[24:25], v[24:25], v[4:5] op_sel_hi:[1,0]
    v_pk_add_f32 v[26:27], v[26:27], v[4:5] op_sel_hi:[1,0]
    v_pk_fma_f32 v[6:7], v[20:21], v[20:21], s[22:23]
    v_pk_fma_f32 v[6:7], v[22:23], v[22:23], v[6:7]
    v_pk_fma_f32 v[6:7], v[24:25], v[24:25], v[6:7]
    v_pk_fma_f32 v[6:7], v[26:27], v[26:27], v[6:7]
    v_add_f32 v4, v6, v7
    s_waitcnt vmcnt(1)
    v_lshlrev_b32 v16, 16, v16
    v_add_f32_dpp v4, v4, v4 row_ror:8 row_mask:0xf bank_mask:0xf
    v_lshlrev_b32 v5, 16, v5
    v_mul_f32 v16, 0x413504f3, v16
    v_add_f32_dpp v4, v4, v4 row_ror:4 row_mask:0xf bank_mask:0xf
    s_nop 1
    v_add_f32_dpp v4, v4, v4 row_ror:2 row_mask:0xf bank_mask:0xf
    s_nop 1
    v_add_f32_dpp v4, v4, v4 row_ror:1 row_mask:0xf bank_mask:0xf
    v_rsq_f32 v4, v4
    s_nop 0
    v_mul_f32 v4, v4, v16
    v_pk_fma_f32 v[20:21], v[20:21], v[4:5], v[4:5] op_sel:[0,0,1] op_sel_hi:[1,0,1]
    v_pk_fma_f32 v[22:23], v[22:23], v[4:5], v[4:5] op_sel:[0,0,1] op_sel_hi:[1,0,1]
    v_pk_fma_f32 v[24:25], v[24:25], v[4:5], v[4:5] op_sel:[0,0,1] op_sel_hi:[1,0,1]
    v_pk_fma_f32 v[26:27], v[26:27], v[4:5], v[4:5] op_sel:[0,0,1] op_sel_hi:[1,0,1]
    v_cvt_pk_bf16_f32 v28, v20, v21
    v_cvt_pk_bf16_f32 v29, v22, v23
    v_cvt_pk_bf16_f32 v30, v24, v25
    v_cvt_pk_bf16_f32 v31, v26, v27
    global_store_dwordx4 v1, v[28:31], s[10:11] sc0 sc1
    s_waitcnt vmcnt(1)
    s_load_dword s40, s[16:17], 0
    v_dot2_f32_bf16 v4, v12, s20, 0
    v_dot2_f32_bf16 v4, v13, s20, v4
    v_dot2_f32_bf16 v4, v14, s20, v4
    v_dot2_f32_bf16 v4, v15, s20, v4
    v_mfma_f32_4x4x4_16b_bf16 v[20:23], v[18:19], v[12:13], 0
    v_mfma_f32_4x4x4_16b_bf16 v[24:27], v[18:19], v[14:15], 0
    s_nop 0
    v_add_f32_dpp v4, v4, v4 row_ror:8 row_mask:0xf bank_mask:0xf
    s_nop 1
    v_add_f32_dpp v4, v4, v4 row_ror:4 row_mask:0xf bank_mask:0xf
    s_nop 1
    v_add_f32_dpp v4, v4, v4 row_ror:2 row_mask:0xf bank_mask:0xf
    s_nop 1
    v_add_f32_dpp v4, v4, v4 row_ror:1 row_mask:0xf bank_mask:0xf
    s_waitcnt lgkmcnt(0)
    s_cmp_eq_u32 s40, 0
    s_cbranch_scc1 L_slow
L_known:
    s_bitcmp1_b32 s40, s30
    s_cselect_b32 s26, s27, s26
    v_xor_b32 v2, s26, v1
    global_load_dwordx4 v[8:11], v2, s[4:5] nt
    v_pk_add_f32 v[20:21], v[20:21], v[4:5] op_sel_hi:[1,0]
    v_pk_add_f32 v[22:23], v[22:23], v[4:5] op_sel_hi:[1,0]
    v_pk_add_f32 v[24:25], v[24:25], v[4:5] op_sel_hi:[1,0]
    v_pk_add_f32 v[26:27], v[26:27], v[4:5] op_sel_hi:[1,0]
    v_pk_fma_f32 v[6:7], v[20:21], v[20:21], s[22:23]
    v_pk_fma_f32 v[6:7], v[22:23], v[22:23], v[6:7]
    v_pk_fma_f32 v[6:7], v[24:25], v[24:25], v[6:7]
    v_pk_fma_f32 v[6:7], v[26:27], v[26:27], v[6:7]
    v_add_f32 v4, v6, v7
    s_bitcmp1_b32 s40, s31
    s_cselect_b32 s28, s29, s28
    v_add_f32_dpp v4, v4, v4 row_ror:8 row_mask:0xf bank_mask:0xf
    v_xor_b32 v3, s28, v1
    s_nop 0
    v_add_f32_dpp v4, v4, v4 row_ror:4 row_mask:0xf bank_mask:0xf
    s_nop 1
    v_add_f32_dpp v4, v4, v4 row_ror:2 row_mask:0xf bank_mask:0xf
    s_nop 1
    v_add_f32_dpp v4, v4, v4 row_ror:1 row_mask:0xf bank_mask:0xf
    v_rsq_f32 v4, v4
    s_nop 0
    v_mul_f32 v4, v4, v16
    v_pk_fma_f32 v[20:21], v[20:21], v[4:5], v[4:5] op_sel:[0,0,1] op_sel_hi:[1,0,1]
    v_pk_fma_f32 v[22:23], v[22:23], v[4:5], v[4:5] op_sel:[0,0,1] op_sel_hi:[1,0,1]
    v_pk_fma_f32 v[24:25], v[24:25], v[4:5], v[4:5] op_sel:[0,0,1] op_sel_hi:[1,0,1]
    v_pk_fma_f32 v[26:27], v[26:27], v[4:5], v[4:5] op_sel:[0,0,1] op_sel_hi:[1,0,1]
    v_cvt_pk_bf16_f32 v28, v20, v21
    v_cvt_pk_bf16_f32 v29, v22, v23
    v_cvt_pk_bf16_f32 v30, v24, v25
    v_cvt_pk_bf16_f32 v31, v26, v27
    global_store_dwordx4 v0, v[28:31], s[10:11] sc0 sc1
    s_waitcnt vmcnt(1)
    global_load_dwordx4 v[12:15], v3, s[4:5] nt
    v_dot2_f32_bf16 v4, v8, s20, 0
    v_dot2_f32_bf16 v4, v9, s20, v4
    v_dot2_f32_bf16 v4, v10, s20, v4
    v_dot2_f32_bf16 v4, v11, s20, v4
    v_mfma_f32_4x4x4_16b_bf16 v[20:23], v[18:19], v[8:9], 0
    v_mfma_f32_4x4x4_16b_bf16 v[24:27], v[18:19], v[10:11], 0
    s_nop 0
    v_add_f32_dpp v4, v4, v4 row_ror:8 row_mask:0xf bank_mask:0xf
    s_nop 1
    v_add_f32_dpp v4, v4, v4 row_ror:4 row_mask:0xf bank_mask:0xf
    s_nop 1
    v_add_f32_dpp v4, v4, v4 row_ror:2 row_mask:0xf bank_mask:0xf
    s_nop 1
    v_add_f32_dpp v4, v4, v4 row_ror:1 row_mask:0xf bank_mask:0xf
    v_pk_add_f32 v[20:21], v[20:21], v[4:5] op_sel_hi:[1,0]
    v_pk_add_f32 v[22:23], v[22:23], v[4:5] op_sel_hi:[1,0]
    v_pk_add_f32 v[24:25], v[24:25], v[4:5] op_sel_hi:[1,0]
    v_pk_add_f32 v[26:27], v[26:27], v[4:5] op_sel_hi:[1,0]
    v_pk_fma_f32 v[6:7], v[20:21], v[20:21], s[22:23]
    v_pk_fma_f32 v[6:7], v[22:23], v[22:23], v[6:7]
    v_pk_fma_f32 v[6:7], v[24:25], v[24:25], v[6:7]
    v_pk_fma_f32 v[6:7], v[26:27], v[26:27], v[6:7]
    v_add_f32 v4, v6, v7
    s_nop 1
    v_add_f32_dpp v4, v4, v4 row_ror:8 row_mask:0xf bank_mask:0xf
    s_nop 1
    v_add_f32_dpp v4, v4, v4 row_ror:4 row_mask:0xf bank_mask:0xf
    s_nop 1
    v_add_f32_dpp v4, v4, v4 row_ror:2 row_mask:0xf bank_mask:0xf
    s_nop 1
    v_add_f32_dpp v4, v4, v4 row_ror:1 row_mask:0xf bank_mask:0xf
    v_rsq_f32 v4, v4
    s_nop 0
    v_mul_f32 v4, v4, v16
    v_pk_fma_f32 v[20:21], v[20:21], v[4:5], v[4:5] op_sel:[0,0,1] op_sel_hi:[1,0,1]
    v_pk_fma_f32 v[22:23], v[22:23], v[4:5], v[4:5] op_sel:[0,0,1] op_sel_hi:[1,0,1]
    v_pk_fma_f32 v[24:25], v[24:25], v[4:5], v[4:5] op_sel:[0,0,1] op_sel_hi:[1,0,1]
    v_pk_fma_f32 v[26:27], v[26:27], v[4:5], v[4:5] op_sel:[0,0,1] op_sel_hi:[1,0,1]
    v_cvt_pk_bf16_f32 v28, v20, v21
    v_cvt_pk_bf16_f32 v29, v22, v23
    v_cvt_pk_bf16_f32 v30, v24, v25
    v_cvt_pk_bf16_f32 v31, v26, v27
    global_store_dwordx4 v2, v[28:31], s[10:11] sc0 sc1
    s_waitcnt vmcnt(1)
    v_dot2_f32_bf16 v4, v12, s20, 0
    v_dot2_f32_bf16 v4, v13, s20, v4
    v_dot2_f32_bf16 v4, v14, s20, v4
    v_dot2_f32_bf16 v4, v15, s20, v4
    v_mfma_f32_4x4x4_16b_bf16 v[20:23], v[18:19], v[12:13], 0
    v_mfma_f32_4x4x4_16b_bf16 v[24:27], v[18:19], v[14:15], 0
    s_nop 0
    v_add_f32_dpp v4, v4, v4 row_ror:8 row_mask:0xf bank_mask:0xf
    s_nop 1
    v_add_f32_dpp v4, v4, v4 row_ror:4 row_mask:0xf bank_mask:0xf
    s_nop 1
    v_add_f32_dpp v4, v4, v4 row_ror:2 row_mask:0xf bank_mask:0xf
    s_nop 1
    v_add_f32_dpp v4, v4, v4 row_ror:1 row_mask:0xf bank_mask:0xf
    v_pk_add_f32 v[20:21], v[20:21], v[4:5] op_sel_hi:[1,0]
    v_pk_add_f32 v[22:23], v[22:23], v[4:5] op_sel_hi:[1,0]
    v_pk_add_f32 v[24:25], v[24:25], v[4:5] op_sel_hi:[1,0]
    v_pk_add_f32 v[26:27], v[26:27], v[4:5] op_sel_hi:[1,0]
    v_pk_fma_f32 v[6:7], v[20:21], v[20:21], s[22:23]
    v_pk_fma_f32 v[6:7], v[22:23], v[22:23], v[6:7]
    v_pk_fma_f32 v[6:7], v[24:25], v[24:25], v[6:7]
    v_pk_fma_f32 v[6:7], v[26:27], v[26:27], v[6:7]
    v_add_f32 v4, v6, v7
    s_nop 1
    v_add_f32_dpp v4, v4, v4 row_ror:8 row_mask:0xf bank_mask:0xf
    s_nop 1
    v_add_f32_dpp v4, v4, v4 row_ror:4 row_mask:0xf bank_mask:0xf
    s_nop 1
    v_add_f32_dpp v4, v4, v4 row_ror:2 row_mask:0xf bank_mask:0xf
    s_nop 1
    v_add_f32_dpp v4, v4, v4 row_ror:1 row_mask:0xf bank_mask:0xf
    v_rsq_f32 v4, v4
    s_nop 0
    v_mul_f32 v4, v4, v16
    v_pk_fma_f32 v[20:21], v[20:21], v[4:5], v[4:5] op_sel:[0,0,1] op_sel_hi:[1,0,1]
    v_pk_fma_f32 v[22:23], v[22:23], v[4:5], v[4:5] op_sel:[0,0,1] op_sel_hi:[1,0,1]
    v_pk_fma_f32 v[24:25], v[24:25], v[4:5], v[4:5] op_sel:[0,0,1] op_sel_hi:[1,0,1]
    v_pk_fma_f32 v[26:27], v[26:27], v[4:5], v[4:5] op_sel:[0,0,1] op_sel_hi:[1,0,1]
    v_cvt_pk_bf16_f32 v28, v20, v21
    v_cvt_pk_bf16_f32 v29, v22, v23
    v_cvt_pk_bf16_f32 v30, v24, v25
    v_cvt_pk_bf16_f32 v31, v26, v27
    global_store_dwordx4 v3, v[28:31], s[10:11] sc0 sc1
L_end:
    s_endpgm

L_slow:
    s_add_u32 s3, s2, 32
    v_mov_b32 v6, 0xff0
    v_mov_b32 v7, 0
    s_mov_b64 exec, 1
L_poll:
    global_load_dword v17, v7, s[16:17] sc1
    s_sub_u32 s3, s3, 1
    s_cbranch_scc0 L_poll2
    global_atomic_cmpswap v7, v[6:7], s[16:17] sc1
L_poll2:
    s_waitcnt vmcnt(0)
    v_readfirstlane_b32 s40, v17
    s_nop 3
    s_cmp_eq_u32 s40, 0
    s_cbranch_scc1 L_poll
    s_mov_b64 exec, -1
    s_branch L_known
.section .rodata,"a"
.p2align 6
.amdhsa_kernel standalone__instancenorm__sampling_kernel
  .amdhsa_next_free_vgpr 32
  .amdhsa_next_free_sgpr 41
  .amdhsa_accum_offset 32
  .amdhsa_group_segment_fixed_size 0
  .amdhsa_kernarg_size 48
  .amdhsa_user_sgpr_count 2
  .amdhsa_user_sgpr_kernarg_segment_ptr 1
  .amdhsa_system_sgpr_workgroup_id_x 1
  .amdhsa_float_denorm_mode_32 3
.end_amdhsa_kernel
```
